```python
import torch

def _softmax(x, axis=-1):
    return torch.softmax(x, dim=axis)
def _gelu(x):
    return torch.nn.functional.gelu(x, approximate="tanh")
def _silu(x):
    return torch.nn.functional.silu(x)
def _sigmoid(x):
    return torch.sigmoid(x)
def _layernorm(x, axis=-1, eps=1e-5):
    m = x.mean(dim=axis, keepdim=True)
    v = x.var(dim=axis, keepdim=True, unbiased=False)
    return (x - m) / torch.sqrt(v + eps)
def _scatter_add(tgt, idx, src, axis=0):
    return tgt.clone().index_add_(axis, idx, src)
def _segment_sum(src, seg, n):
    out = torch.zeros((n,) + src.shape[1:], dtype=src.dtype)
    return out.index_add_(0, seg, src)
def _pad(x, pw):
    flat = tuple(v for pair in reversed(pw) for v in pair)
    return torch.nn.functional.pad(x, flat)

kernel_name = 'recurrent_scan__sliding_block_cached__mixer_channel_mlp__decode'

def setup_inputs():

    _w = (lambda a: (lambda t: t.to(torch.bfloat16) if t.is_floating_point() else t)(torch.as_tensor(a)))
    def _A_setup():
        B, Sq, D = 1, 1, 512
        Hq, Hkv, Sk, Dh = 32, 8, 32768, 128
        assert Hq % Hkv == 0, (Hq, Hkv)
        return {
            "x": _w((lambda *s: torch.randn(*s, dtype=torch.bfloat16) * 0.1)(B, Sq, D)),
            "k_cache": _w((lambda *s: torch.randn(*s, dtype=torch.bfloat16) * 0.8)(B, Hkv, Sk, Dh)),
            "v_cache": _w((lambda *s: torch.randn(*s, dtype=torch.bfloat16) * 3.2)(B, Hkv, Sk, Dh)),
            "wq": _w((lambda *s: torch.randn(*s, dtype=torch.bfloat16) * 0.8)(D, Hq * Dh) * (D ** -0.5)),
            "wo": _w((lambda *s: torch.randn(*s, dtype=torch.bfloat16) * 3.2)(Hq * Dh, D) * ((Hq * Dh) ** -0.5)),
        }
    _A_in = _A_setup()

    def _B_setup():
        B, S, D, F = 1, 1, 512, 1792
        return {
            "x": _w((lambda *s: torch.randn(*s, dtype=torch.bfloat16) * 0.1)(B, S, D)),
            "w1": _w((lambda *s: torch.randn(*s, dtype=torch.bfloat16) * 3.2)(D, F) * (D ** -0.5)),
            "b1": _w((lambda *s: torch.randn(*s, dtype=torch.bfloat16) * 3.2)(F)),
            "w2": _w((lambda *s: torch.randn(*s, dtype=torch.bfloat16) * 3.2)(F, D) * (F ** -0.5)),
            "b2": _w((lambda *s: torch.randn(*s, dtype=torch.bfloat16) * 3.2)(D)),
        }
    _B_in = _B_setup()

    return {
        "A_x": _A_in["x"],
        "A_k_cache": _A_in["k_cache"],
        "A_v_cache": _A_in["v_cache"],
        "A_wq": _A_in["wq"],
        "A_wo": _A_in["wo"],
        "B_x": _B_in["x"],
        "B_w1": _B_in["w1"],
        "B_b1": _B_in["b1"],
        "B_w2": _B_in["w2"],
        "B_b2": _B_in["b2"],
    }

def reference(A_x, A_k_cache, A_v_cache, A_wq, A_wo, B_x, B_w1, B_b1, B_w2, B_b2):
    def _A_ref(x, k_cache, v_cache, wq, wo):
        B, Sq, D = x.shape
        Hq, Dh = 32, 128
        Hkv, Sk = k_cache.shape[1], k_cache.shape[2]
        W = min(4096, max(256, Sk // 4))
        rep = Hq // Hkv
        q = (lambda x, *d: x.permute(*d))((x @ wq).reshape(B, Sq, Hq, Dh), 0, 2, 1, 3)
        k = (lambda x, n, axis: torch.repeat_interleave(x, n, dim=axis))(k_cache[:, :, Sk - W:, :], rep, axis=1)
        v = (lambda x, n, axis: torch.repeat_interleave(x, n, dim=axis))(v_cache[:, :, Sk - W:, :], rep, axis=1)
        scores = torch.einsum("bhqd,bhkd->bhqk", q, k) * (Dh ** -0.5)
        p = _softmax(scores, axis=-1)
        o = torch.einsum("bhqk,bhkd->bhqd", p, v)
        return (lambda x, *d: x.permute(*d))(o, 0, 2, 1, 3).reshape(B, Sq, Hq * Dh) @ wo

    def _B_ref(x, w1, b1, w2, b2):
        y = _layernorm(x, axis=-1)
        h = _gelu(torch.einsum("bsd,df->bsf", y, w1) + b1)
        return torch.einsum("bsf,fd->bsd", h, w2) + b2

    x = A_x
    xn = _layernorm(x, axis=-1)
    s = _A_ref(xn, A_k_cache, A_v_cache, A_wq, A_wo)
    g = _silu(_B_ref(xn, B_w1, B_b1, B_w2, B_b2))
    return x + s * g
```

```asm
; @launch grid=(256,1,1) block=(320,1,1) lds=75776
.amdgcn_target "amdgcn-amd-amdhsa--gfx950"
.text
.p2align 12
.globl recurrent_scan__sliding_block_cached__mixer_channel_mlp__decode_kernel
.p2align 8
.type recurrent_scan__sliding_block_cached__mixer_channel_mlp__decode_kernel,@function
recurrent_scan__sliding_block_cached__mixer_channel_mlp__decode_kernel:
    s_cmp_ge_u32 s2, 256
    s_cbranch_scc1 L_end
    s_load_dwordx16 s[4:19], s[0:1], 0
    s_load_dwordx8 s[20:27], s[0:1], 64
    s_load_dwordx2 s[28:29], s[0:1], 96
    s_getpc_b64 s[34:35]
L_pc:
    v_lshlrev_b32 v2, 7, v0
    v_min_u32 v2, L_end-L_pc, v2
    v_cmp_gt_u32 vcc, L_end-L_pc, v2
    s_nop 0
    s_and_b64 exec, exec, vcc
    s_cbranch_execz L_pref_skip
    global_load_dword v15, v2, s[34:35]
L_pref_skip:
    s_mov_b64 exec, -1
    v_lshrrev_b32 v3, 6, v0
    v_and_b32 v1, 63, v0
    v_readfirstlane_b32 s32, v3
    s_and_b32 s30, s2, 7
    s_lshr_b32 s31, s2, 3
    v_lshrrev_b32 v16, 4, v1
    v_lshrrev_b32 v18, 3, v1
    v_and_b32 v19, 7, v1
    v_mov_b32 v28, 0
    s_cmp_gt_u32 s30, 4
    s_subb_u32 s59, s30, 0
    s_lshl_b32 s59, s59, 5
    s_add_u32 s59, s59, s31
    s_cmp_lg_u32 s30, 4
    s_cselect_b32 s48, 1, 0
    s_cmp_eq_u32 s32, 4
    s_cbranch_scc1 L_comm0
    v_lshlrev_b32 v84, 4, v1
    s_and_b32 s36, s31, 3
    s_lshl2_add_u32 s36, s36, s32
    s_lshl_b32 s39, s36, 6
    s_lshl_b32 s36, s36, 18
    s_lshr_b32 s38, s31, 2
    s_lshl3_add_u32 s37, s30, s38
    s_lshl_b32 s37, s37, 7
    s_add_u32 s36, s36, s37
    v_lshl_add_u32 v86, v18, 3, s39
    v_lshlrev_b32 v2, 4, v19
    v_lshl_or_b32 v3, v18, 15, v2
    v_add_u32 v88, s36, v3
    v_add_u32 v89, 0x2000, v88
    v_add_u32 v90, 0x4000, v88
    v_add_u32 v91, 0x6000, v88
    s_and_b32 s36, s59, 7
    s_lshl2_add_u32 s36, s36, s32
    s_lshl_b32 s39, s36, 5
    s_mul_i32 s36, s36, 57344
    s_lshr_b32 s37, s59, 3
    s_lshl_b32 s37, s37, 7
    s_add_u32 s36, s36, s37
    v_lshl_add_u32 v87, v18, 2, s39
    v_mul_u32_u24 v3, 7168, v18
    v_add3_u32 v3, v3, v2, s36
    v_mul_u32_u24 v85, s48, v3
    s_waitcnt lgkmcnt(0)
    global_load_dwordx4 v[124:127], v84, s[4:5]
    global_load_dwordx2 v[148:149], v86, s[4:5]
    global_load_dword v150, v87, s[4:5]
    s_mov_b64 exec, 1
    global_load_dword v15, v28, s[28:29]
    s_mov_b64 exec, -1
    s_barrier
    global_load_dwordx4 v[52:55], v88, s[10:11] nt
    global_load_dwordx4 v[56:59], v89, s[10:11] nt
    global_load_dwordx4 v[60:63], v90, s[10:11] nt
    global_load_dwordx4 v[64:67], v91, s[10:11] nt
    s_barrier
    global_load_dwordx4 v[68:71], v85, s[16:17] offset:0 nt
    global_load_dwordx4 v[72:75], v85, s[16:17] offset:3584 nt
    s_branch L_c1
L_comm0:
    s_waitcnt lgkmcnt(0)
    s_mov_b64 exec, 1
    global_load_dword v15, v28, s[28:29]
    s_mov_b64 exec, -1
    s_barrier
    s_barrier
    s_branch L_comm
L_c1:
    v_and_b32 v17, 15, v1
    s_lshl_b32 s36, s30, 23
    s_lshl_b32 s37, s31, 12
    s_add_u32 s36, s36, s37
    s_lshl_b32 s37, s32, 10
    s_add_u32 s36, s36, s37
    s_add_u32 s39, s36, 0x700000
    s_lshl_b32 s37, s32, 13
    s_add_u32 s56, s37, 10240
    s_lshl_b32 s37, s32, 11
    s_add_u32 s57, s37, 43008
    v_xor_b32 v3, v17, v16
    v_lshlrev_b32 v3, 4, v3
    v_lshl_or_b32 v4, v16, 8, v3
    v_or_b32 v30, s39, v4
    s_add_u32 m0, s56, 0
    s_nop 0
    global_load_lds_dwordx4 v30, s[6:7] nt
    v_xor_b32 v9, 0x20040, v30
    s_add_u32 m0, s56, 1024
    s_nop 0
    global_load_lds_dwordx4 v9, s[6:7] nt
    v_xor_b32 v9, 0x40080, v30
    s_add_u32 m0, s56, 2048
    s_nop 0
    global_load_lds_dwordx4 v9, s[6:7] nt
    v_lshl_add_u32 v3, v17, 8, v3
    v_add_u32 v37, s56, v3
    v_lshlrev_b32 v3, 1, v16
    v_xor_b32 v3, v17, v3
    v_lshlrev_b32 v3, 4, v3
    v_lshl_or_b32 v3, v16, 8, v3
    v_or_b32 v31, s39, v3
    s_lshl_b32 s33, s30, 5
    s_add_u32 s33, s33, s31
    s_mov_b32 s42, 0xfffff000
    s_mov_b32 s43, 0xffff0000
    s_mov_b32 s47, 0
    s_getreg_b32 s3, hwreg(HW_REG_XCC_ID, 0, 4)
    s_mov_b32 s44, 0x01000100
    s_mov_b32 s45, 0x03020302
    s_mov_b32 s46, 0x3fb8aa3b
    v_and_b32 v20, 1, v1
    v_lshrrev_b32 v21, 5, v1
    v_and_b32 v22, 1, v16
    v_and_b32 v23, 3, v1
    v_lshrrev_b32 v24, 2, v1
    v_lshlrev_b32 v3, 4, v20
    v_mov_b32 v4, 0xffff
    v_lshlrev_b32 v3, v3, v4
    v_bfe_u32 v4, v1, 1, 2
    v_cmp_eq_u32 s[50:51], 0, v4
    v_cmp_eq_u32 s[52:53], 1, v4
    v_cmp_eq_u32 s[54:55], 2, v4
    v_cmp_eq_u32 vcc, 3, v4
    v_cndmask_b32 v10, 0, v3, s[50:51]
    v_cndmask_b32 v11, 0, v3, s[52:53]
    v_cndmask_b32 v12, 0, v3, s[54:55]
    v_cndmask_b32 v13, 0, v3, vcc
    s_lshl_b32 s36, s32, 9
    s_add_u32 s36, s36, 2048
    v_lshlrev_b32 v3, 8, v21
    v_lshl_add_u32 v3, v19, 5, v3
    v_lshl_add_u32 v3, v22, 4, v3
    v_add_u32 v32, s36, v3
    v_lshlrev_b32 v3, 5, v17
    v_lshl_add_u32 v3, v16, 4, v3
    v_add_u32 v50, s36, v3
    s_waitcnt vmcnt(9)
    v_readfirstlane_b32 s36, v15
    v_lshlrev_b32 v132, 16, v124
    v_and_b32 v133, s43, v124
    v_lshlrev_b32 v134, 16, v125
    v_and_b32 v135, s43, v125
    v_lshlrev_b32 v136, 16, v126
    v_and_b32 v137, s43, v126
    v_lshlrev_b32 v138, 16, v127
    v_and_b32 v139, s43, v127
    s_mul_i32 s36, s36, 1664525
    s_add_u32 s40, s36, 1013904223
    s_and_b32 s41, s40, 0xfff
    s_xor_b32 s3, s3, s41
    v_mov_b32 v14, s41
    v_pk_add_f32 v[140:141], v[132:133], v[134:135]
    v_pk_add_f32 v[142:143], v[136:137], v[138:139]
    v_pk_add_f32 v[140:141], v[140:141], v[142:143]
    v_add_f32 v2, v140, v141
    v_mov_b32 v5, 0x3b000000
    s_lshl2_add_u32 s37, s30, s32
    v_add_f32_dpp v2, v2, v2 row_ror:8 row_mask:0xf bank_mask:0xf
    s_lshl_b32 s37, s37, 11
    s_add_u32 s37, s37, 65536
    v_add_f32_dpp v2, v2, v2 row_ror:4 row_mask:0xf bank_mask:0xf
    v_lshlrev_b32 v7, 10, v22
    v_lshl_add_u32 v7, v21, 9, v7
    v_add_f32_dpp v2, v2, v2 row_ror:2 row_mask:0xf bank_mask:0xf
    v_lshl_add_u32 v7, v17, 4, v7
    v_add_u32 v33, s37, v7
    v_add_f32_dpp v2, v2, v2 row_ror:1 row_mask:0xf bank_mask:0xf
    s_andn2_b32 s39, s59, 7
    s_lshl_b32 s37, s39, 8
    v_add_f32_dpp v2, v2, v2 row_bcast:15 row_mask:0xa bank_mask:0xf
    s_bfe_u32 s38, s59, 0x10002
    s_lshl2_add_u32 s38, s38, s32
    v_add_f32_dpp v2, v2, v2 row_bcast:31 row_mask:0xc bank_mask:0xf
    s_lshl_b32 s38, s38, 5
    v_readlane_b32 s49, v2, 63
    s_add_u32 s37, s37, s38
    s_add_u32 s37, s37, 131072
    v_mul_f32 v4, s49, v5
    v_pk_add_f32 v[140:141], v[132:133], v[4:5] op_sel_hi:[1,0] neg_lo:[0,1] neg_hi:[0,1]
    v_pk_add_f32 v[142:143], v[134:135], v[4:5] op_sel_hi:[1,0] neg_lo:[0,1] neg_hi:[0,1]
    v_pk_add_f32 v[144:145], v[136:137], v[4:5] op_sel_hi:[1,0] neg_lo:[0,1] neg_hi:[0,1]
    v_pk_add_f32 v[146:147], v[138:139], v[4:5] op_sel_hi:[1,0] neg_lo:[0,1] neg_hi:[0,1]
    v_pk_mul_f32 v[2:3], v[140:141], v[140:141]
    v_pk_fma_f32 v[2:3], v[142:143], v[142:143], v[2:3]
    v_pk_fma_f32 v[2:3], v[144:145], v[144:145], v[2:3]
    v_pk_fma_f32 v[2:3], v[146:147], v[146:147], v[2:3]
    v_add_f32 v2, v2, v3
    v_cvt_pk_bf16_f32 v4, 0, v4
    v_lshlrev_b32 v7, 8, v18
    v_add_f32_dpp v2, v2, v2 row_ror:8 row_mask:0xf bank_mask:0xf
    v_lshl_add_u32 v7, v20, 4, v7
    v_add_u32 v34, s37, v7
    v_add_f32_dpp v2, v2, v2 row_ror:4 row_mask:0xf bank_mask:0xf
    s_andn2_b32 s37, s59, 3
    s_add_u32 s37, s37, s32
    v_add_f32_dpp v2, v2, v2 row_ror:2 row_mask:0xf bank_mask:0xf
    s_lshl_b32 s37, s37, 3
    v_lshl_add_u32 v7, v20, 2, v16
    v_add_f32_dpp v2, v2, v2 row_ror:1 row_mask:0xf bank_mask:0xf
    v_add_lshl_u32 v7, v7, s37, 1
    v_mul_u32_u24 v51, s48, v7
    v_add_f32_dpp v2, v2, v2 row_bcast:15 row_mask:0xa bank_mask:0xf
    v_lshlrev_b32 v8, 10, v16
    v_lshl_add_u32 v8, v17, 4, v8
    v_add_f32_dpp v2, v2, v2 row_bcast:31 row_mask:0xc bank_mask:0xf
    s_and_b32 s39, s31, 3
    v_readlane_b32 s49, v2, 63
    s_lshl_b32 s39, s39, 8
    s_lshl_b32 s37, s37, 10
    v_mul_f32 v6, s49, v5
    v_cvt_pk_bf16_f32 v6, 0, v6
    v_add_f32 v6, 0x3727c5ac, v6
    v_cvt_pk_bf16_f32 v6, 0, v6
    v_sqrt_f32 v6, v6
    s_add_u32 s37, s37, s39
    v_cvt_pk_bf16_f32 v6, 0, v6
    v_rcp_f32 v6, v6
    v_lshlrev_b32 v116, 16, v148
    v_and_b32 v117, s43, v148
    v_lshlrev_b32 v118, 16, v149
    v_and_b32 v119, s43, v149
    v_lshlrev_b32 v120, 16, v150
    v_and_b32 v121, s43, v150
    v_pk_add_f32 v[116:117], v[116:117], v[4:5] op_sel_hi:[1,0] neg_lo:[0,1] neg_hi:[0,1]
    v_pk_add_f32 v[118:119], v[118:119], v[4:5] op_sel_hi:[1,0] neg_lo:[0,1] neg_hi:[0,1]
    v_pk_add_f32 v[120:121], v[120:121], v[4:5] op_sel_hi:[1,0] neg_lo:[0,1] neg_hi:[0,1]
    v_cvt_pk_bf16_f32 v116, 0, v116
    v_cvt_pk_bf16_f32 v117, 0, v117
    v_cvt_pk_bf16_f32 v118, 0, v118
    v_cvt_pk_bf16_f32 v119, 0, v119
    v_cvt_pk_bf16_f32 v120, 0, v120
    v_cvt_pk_bf16_f32 v121, 0, v121
    v_pk_mul_f32 v[116:117], v[116:117], v[6:7] op_sel_hi:[1,0]
    v_pk_mul_f32 v[118:119], v[118:119], v[6:7] op_sel_hi:[1,0]
    v_pk_mul_f32 v[120:121], v[120:121], v[6:7] op_sel_hi:[1,0]
    v_cvt_pk_bf16_f32 v148, v116, v117
    v_cvt_pk_bf16_f32 v149, v118, v119
    v_cvt_pk_bf16_f32 v120, 0, v120
    v_cvt_pk_bf16_f32 v121, 0, v121
    v_perm_b32 v2, v148, v148, s44
    v_and_b32 v100, v2, v10
    v_and_b32 v101, v2, v11
    v_and_b32 v102, v2, v12
    v_and_b32 v103, v2, v13
    v_perm_b32 v2, v148, v148, s45
    v_and_b32 v104, v2, v10
    v_and_b32 v105, v2, v11
    v_and_b32 v106, v2, v12
    v_and_b32 v107, v2, v13
    v_perm_b32 v2, v149, v149, s44
    v_and_b32 v108, v2, v10
    v_and_b32 v109, v2, v11
    v_and_b32 v110, v2, v12
    v_and_b32 v111, v2, v13
    v_perm_b32 v2, v149, v149, s45
    v_and_b32 v112, v2, v10
    v_and_b32 v113, v2, v11
    v_and_b32 v114, v2, v12
    v_and_b32 v115, v2, v13
    v_xor_b32 v9, 0x600c0, v30
    s_add_u32 m0, s56, 3072
    v_add_u32 v7, s37, v8
    global_load_lds_dwordx4 v9, s[6:7] nt
    v_pk_add_f32 v[132:133], v[132:133], v[4:5] op_sel_hi:[1,0] neg_lo:[0,1] neg_hi:[0,1]
    v_pk_add_f32 v[134:135], v[134:135], v[4:5] op_sel_hi:[1,0] neg_lo:[0,1] neg_hi:[0,1]
    v_pk_add_f32 v[136:137], v[136:137], v[4:5] op_sel_hi:[1,0] neg_lo:[0,1] neg_hi:[0,1]
    v_pk_add_f32 v[138:139], v[138:139], v[4:5] op_sel_hi:[1,0] neg_lo:[0,1] neg_hi:[0,1]
    v_cvt_pk_bf16_f32 v132, 0, v132
    v_cvt_pk_bf16_f32 v133, 0, v133
    v_cvt_pk_bf16_f32 v134, 0, v134
    v_cvt_pk_bf16_f32 v135, 0, v135
    v_cvt_pk_bf16_f32 v136, 0, v136
    v_cvt_pk_bf16_f32 v137, 0, v137
    v_cvt_pk_bf16_f32 v138, 0, v138
    v_cvt_pk_bf16_f32 v139, 0, v139
    v_pk_mul_f32 v[132:133], v[132:133], v[6:7] op_sel_hi:[1,0]
    v_pk_mul_f32 v[134:135], v[134:135], v[6:7] op_sel_hi:[1,0]
    v_pk_mul_f32 v[136:137], v[136:137], v[6:7] op_sel_hi:[1,0]
    v_pk_mul_f32 v[138:139], v[138:139], v[6:7] op_sel_hi:[1,0]
    v_cvt_pk_bf16_f32 v132, 0, v132
    v_cvt_pk_bf16_f32 v133, 0, v133
    v_cvt_pk_bf16_f32 v134, 0, v134
    v_cvt_pk_bf16_f32 v135, 0, v135
    v_cvt_pk_bf16_f32 v136, 0, v136
    v_cvt_pk_bf16_f32 v137, 0, v137
    v_cvt_pk_bf16_f32 v138, 0, v138
    v_cvt_pk_bf16_f32 v139, 0, v139
    v_pk_add_f32 v[140:141], v[132:133], v[134:135]
    v_pk_add_f32 v[142:143], v[136:137], v[138:139]
    v_pk_add_f32 v[140:141], v[140:141], v[142:143]
    v_add_f32 v2, v140, v141
    v_mov_b32 v5, 0x3b000000
    v_mul_u32_u24 v7, s48, v7
    v_add_f32_dpp v2, v2, v2 row_ror:8 row_mask:0xf bank_mask:0xf
    v_add_u32 v49, 0x1000, v7
    s_and_b32 s37, s31, 28
    v_add_f32_dpp v2, v2, v2 row_ror:4 row_mask:0xf bank_mask:0xf
    s_add_u32 s37, s37, s32
    s_lshl_b32 s37, s37, 12
    v_add_f32_dpp v2, v2, v2 row_ror:2 row_mask:0xf bank_mask:0xf
    s_lshl_b32 s38, s30, 19
    s_add_u32 s37, s37, s38
    v_add_f32_dpp v2, v2, v2 row_ror:1 row_mask:0xf bank_mask:0xf
    s_add_u32 s37, s37, s39
    v_add_u32 v47, s37, v8
    v_add_f32_dpp v2, v2, v2 row_bcast:15 row_mask:0xa bank_mask:0xf
    v_mov_b32 v25, 0
    s_mul_i32 s37, s32, 272
    v_add_f32_dpp v2, v2, v2 row_bcast:31 row_mask:0xc bank_mask:0xf
    s_add_u32 s37, s37, 6144
    v_readlane_b32 s49, v2, 63
    v_and_b32 v7, 31, v1
    v_lshlrev_b32 v7, 3, v7
    v_mul_f32 v4, s49, v5
    v_pk_add_f32 v[140:141], v[132:133], v[4:5] op_sel_hi:[1,0] neg_lo:[0,1] neg_hi:[0,1]
    v_pk_add_f32 v[142:143], v[134:135], v[4:5] op_sel_hi:[1,0] neg_lo:[0,1] neg_hi:[0,1]
    v_pk_add_f32 v[144:145], v[136:137], v[4:5] op_sel_hi:[1,0] neg_lo:[0,1] neg_hi:[0,1]
    v_pk_add_f32 v[146:147], v[138:139], v[4:5] op_sel_hi:[1,0] neg_lo:[0,1] neg_hi:[0,1]
    v_pk_mul_f32 v[2:3], v[140:141], v[140:141]
    v_pk_fma_f32 v[2:3], v[142:143], v[142:143], v[2:3]
    v_pk_fma_f32 v[2:3], v[144:145], v[144:145], v[2:3]
    v_pk_fma_f32 v[2:3], v[146:147], v[146:147], v[2:3]
    v_add_f32 v2, v2, v3
    v_cvt_pk_bf16_f32 v4, 0, v4
    v_lshl_add_u32 v7, v21, 2, v7
    v_add_f32_dpp v2, v2, v2 row_ror:8 row_mask:0xf bank_mask:0xf
    v_add_u32 v35, s37, v7
    v_mul_u32_u24 v7, 272, v23
    v_add_f32_dpp v2, v2, v2 row_ror:4 row_mask:0xf bank_mask:0xf
    v_lshl_add_u32 v7, v16, 4, v7
    v_add_u32 v36, 6144, v7
    v_add_f32_dpp v2, v2, v2 row_ror:2 row_mask:0xf bank_mask:0xf
    s_lshl_b32 s37, s32, 5
    s_add_u32 s38, s37, 7424
    v_add_f32_dpp v2, v2, v2 row_ror:1 row_mask:0xf bank_mask:0xf
    v_mul_u32_u24 v7, 528, v17
    v_lshl_add_u32 v7, v21, 7, v7
    v_add_f32_dpp v2, v2, v2 row_bcast:15 row_mask:0xa bank_mask:0xf
    v_lshl_add_u32 v7, v22, 4, v7
    v_add_u32 v38, s38, v7
    v_add_f32_dpp v2, v2, v2 row_bcast:31 row_mask:0xc bank_mask:0xf
    v_mul_u32_u24 v7, 528, v23
    v_readlane_b32 s49, v2, 63
    v_lshl_add_u32 v7, v16, 4, v7
    v_lshrrev_b32 v8, 2, v17
    v_mul_f32 v6, s49, v5
    v_cvt_pk_bf16_f32 v6, 0, v6
    v_add_f32 v6, 0x3727c5ac, v6
    v_cvt_pk_bf16_f32 v6, 0, v6
    v_sqrt_f32 v6, v6
    v_lshl_add_u32 v7, v8, 7, v7
    v_cvt_pk_bf16_f32 v6, 0, v6
    v_rcp_f32 v6, v6
    v_pk_add_f32 v[120:121], v[120:121], v[4:5] op_sel_hi:[1,0] neg_lo:[0,1] neg_hi:[0,1]
    v_cvt_pk_bf16_f32 v120, 0, v120
    v_cvt_pk_bf16_f32 v121, 0, v121
    v_pk_mul_f32 v[120:121], v[120:121], v[6:7] op_sel_hi:[1,0]
    v_cvt_pk_bf16_f32 v150, v120, v121
    v_perm_b32 v2, v150, v150, s44
    v_and_b32 v132, v2, v10
    v_and_b32 v133, v2, v11
    v_and_b32 v134, v2, v12
    v_and_b32 v135, v2, v13
    v_perm_b32 v2, v150, v150, s45
    v_and_b32 v136, v2, v10
    v_and_b32 v137, v2, v11
    v_and_b32 v138, v2, v12
    v_and_b32 v139, v2, v13
    s_waitcnt vmcnt(6)
    v_mfma_f32_16x16x32_bf16 v[116:119], v[100:103], v[52:55], 0
    v_mfma_f32_16x16x32_bf16 v[116:119], v[104:107], v[56:59], v[116:119]
    v_mfma_f32_16x16x32_bf16 v[116:119], v[108:111], v[60:63], v[116:119]
    v_mfma_f32_16x16x32_bf16 v[116:119], v[112:115], v[64:67], v[116:119]
    s_mov_b32 exec_lo, 0x00ff00ff
    s_mov_b32 exec_hi, 0xff00ff00
    s_nop 5
    ds_write_b128 v32, v[116:119] offset:0
    s_mov_b64 exec, -1
    v_xor_b32 v9, 0x80000, v30
    s_add_u32 m0, s56, 4096
    s_nop 0
    global_load_lds_dwordx4 v9, s[6:7] nt
    s_waitcnt lgkmcnt(0)
    s_barrier
    s_waitcnt vmcnt(5)
    v_mfma_f32_16x16x32_bf16 v[116:119], v[132:135], v[68:71], 0
    v_mfma_f32_16x16x32_bf16 v[116:119], v[136:139], v[72:75], v[116:119]
    s_mov_b32 exec_lo, 0x00ff00ff
    s_mov_b32 exec_hi, 0xff00ff00
    s_nop 5
    ds_write_b128 v32, v[116:119] offset:2048
    s_mov_b64 exec, -1
    s_waitcnt lgkmcnt(0)
    s_barrier
    v_add_u32 v39, 7424, v7
    s_lshl_b32 s37, s32, 9
    s_lshl_b32 s38, s33, 11
    s_add_u32 s38, s38, s37
    s_add_u32 s38, s38, 524288
    v_lshlrev_b32 v7, 4, v17
    v_lshl_add_u32 v7, v16, 6, v7
    v_add_u32 v42, s38, v7
    s_lshl_b32 s38, s33, 7
    s_add_u32 s38, s38, 196608
    v_lshl_add_u32 v43, v17, 4, s38
    v_and_b32 v7, 7, v24
    s_lshl_b32 s38, s32, 1
    v_xor_b32 v7, s38, v7
    v_lshlrev_b32 v7, 5, v7
    v_lshl_add_u32 v7, v24, 8, v7
    v_lshl_add_u32 v7, v23, 3, v7
    v_add_u32 v40, 43008, v7
    v_xor_b32 v41, 32, v40
    s_lshl_b32 s37, s30, 16
    s_and_b32 s38, s31, 28
    s_add_u32 s38, s38, s32
    s_lshl_b32 s38, s38, 6
    s_add_u32 s37, s37, s38
    s_add_u32 s37, s37, 524288
    v_lshlrev_b32 v7, 11, v24
    v_lshl_add_u32 v7, v23, 4, v7
    v_add_u32 v44, s37, v7
    v_add_u32 v45, 0x8000, v44
    s_lshl_b32 s37, s30, 12
    s_lshr_b32 s38, s31, 31
    s_lshl4_add_u32 s37, s38, s37
    s_add_u32 s37, s37, 196608
    v_lshl_add_u32 v46, v24, 7, s37
    v_lshl_add_u32 v46, v23, 4, v46
    global_load_short_d16_hi v25, v51, s[18:19]
    s_waitcnt vmcnt(5)
    v_xor_b32 v9, 0xa0040, v30
    s_add_u32 m0, s56, 5120
    s_nop 0
    global_load_lds_dwordx4 v9, s[6:7] nt
    s_waitcnt vmcnt(5)
    v_xor_b32 v9, 0xc0080, v30
    s_add_u32 m0, s56, 6144
    s_nop 0
    global_load_lds_dwordx4 v9, s[6:7] nt
    s_waitcnt vmcnt(5)
    v_xor_b32 v9, 0xe00c0, v30
    s_add_u32 m0, s56, 7168
    s_nop 0
    global_load_lds_dwordx4 v9, s[6:7] nt
    s_waitcnt vmcnt(5)
    global_load_dwordx4 v[100:103], v33, s[28:29] offset:0 sc1
    global_load_dwordx4 v[104:107], v33, s[28:29] offset:256 sc1
    s_waitcnt vmcnt(7)
    s_add_u32 m0, s57, 0
    s_nop 0
    global_load_lds_dwordx4 v31, s[8:9] nt
    s_waitcnt vmcnt(7)
    v_xor_b32 v9, 0x20080, v31
    s_add_u32 m0, s57, 1024
    s_nop 0
    global_load_lds_dwordx4 v9, s[8:9] nt
    s_waitcnt vmcnt(6)
    v_xor_b32 v9, 0x40000, v31
    s_add_u32 m0, s57, 8192
    s_nop 0
    global_load_lds_dwordx4 v9, s[8:9] nt
    s_waitcnt vmcnt(6)
    v_xor_b32 v9, 0x60080, v31
    s_add_u32 m0, s57, 9216
    s_nop 0
    global_load_lds_dwordx4 v9, s[8:9] nt
    v_xor_b32 v3, 0x40, v37
    v_xor_b32 v4, 0x80, v37
    v_xor_b32 v5, 0xc0, v37
    s_waitcnt vmcnt(6)
    ds_read_b128 v[124:127], v37 offset:0
    ds_read_b128 v[128:131], v3 offset:0
    ds_read_b128 v[132:135], v4 offset:0
    ds_read_b128 v[136:139], v5 offset:0
    ds_read_b128 v[140:143], v37 offset:4096
    ds_read_b128 v[144:147], v3 offset:4096
    ds_read_b128 v[148:151], v4 offset:4096
    ds_read_b128 v[152:155], v5 offset:4096
    s_waitcnt vmcnt(4)
L_q_chk:
    v_xor_b32 v100, s3, v100
    v_xor_b32 v101, s41, v101
    v_xor_b32 v102, s41, v102
    v_xor_b32 v103, s41, v103
    v_xor_b32 v104, s3, v104
    v_xor_b32 v105, s41, v105
    v_xor_b32 v106, s41, v106
    v_xor_b32 v107, s41, v107
    v_or3_b32 v2, v101, v102, v103
    v_or3_b32 v2, v2, v105, v106
    v_or_b32 v3, v100, v104
    v_or_b32 v2, v2, v107
    v_and_b32 v4, 0xff0, v3
    v_and_b32 v2, 0xfff, v2
    v_or_b32 v2, v2, v4
    v_cmp_ne_u32 vcc, 0, v2
    s_cbranch_vccnz L_q_retry
    v_and_b32 v3, 15, v3
    v_cmp_ne_u32 vcc, 0, v3
    s_mov_b32 s36, 1
    s_lshl_b32 s37, s32, 2
    s_cbranch_vccnz L_q_far
L_q_sum:
    v_pk_add_f32 v[100:101], v[100:101], v[104:105]
    v_pk_add_f32 v[102:103], v[102:103], v[106:107]
    v_mov_b32 v3, s37
    v_mov_b32 v4, s36
    v_permlane32_swap_b32 v100, v102
    v_permlane32_swap_b32 v101, v103
    v_pk_add_f32 v[100:101], v[100:101], v[102:103]
    ds_write_b32 v3, v4 offset:0
    v_cvt_pk_bf16_f32 v2, v100, v101
    ds_write_b32 v35, v2
    v_xor_b32 v9, 0x80000, v31
    s_add_u32 m0, s57, 16384
    s_nop 0
    global_load_lds_dwordx4 v9, s[8:9] nt
    v_xor_b32 v9, 0xa0080, v31
    s_add_u32 m0, s57, 17408
    s_nop 0
    global_load_lds_dwordx4 v9, s[8:9] nt
    s_waitcnt lgkmcnt(0)
    s_barrier
    ds_read_b128 v[52:55], v36 offset:0
    ds_read_b128 v[56:59], v36 offset:64
    ds_read_b128 v[60:63], v36 offset:128
    ds_read_b128 v[64:67], v36 offset:192
    ds_read_b128 v[100:103], v28 offset:0
    v_xor_b32 v9, 0xc0000, v31
    s_add_u32 m0, s57, 24576
    s_nop 0
    global_load_lds_dwordx4 v9, s[8:9] nt
    v_xor_b32 v9, 0xe0080, v31
    s_add_u32 m0, s57, 25600
    s_nop 0
    global_load_lds_dwordx4 v9, s[8:9] nt
    s_waitcnt lgkmcnt(4)
    v_mfma_f32_16x16x32_bf16 v[116:119], v[124:127], v[52:55], 0
    v_mfma_f32_16x16x32_bf16 v[120:123], v[140:143], v[52:55], 0
    s_waitcnt lgkmcnt(3)
    v_mfma_f32_16x16x32_bf16 v[116:119], v[128:131], v[56:59], v[116:119]
    v_mfma_f32_16x16x32_bf16 v[120:123], v[144:147], v[56:59], v[120:123]
    s_waitcnt lgkmcnt(2)
    v_mfma_f32_16x16x32_bf16 v[116:119], v[132:135], v[60:63], v[116:119]
    v_mfma_f32_16x16x32_bf16 v[120:123], v[148:151], v[60:63], v[120:123]
    s_waitcnt lgkmcnt(1)
    v_mfma_f32_16x16x32_bf16 v[116:119], v[136:139], v[64:67], v[116:119]
    v_mfma_f32_16x16x32_bf16 v[120:123], v[152:155], v[64:67], v[120:123]
    s_waitcnt lgkmcnt(0)
    v_or3_b32 v2, v100, v101, v102
    v_or_b32 v2, v2, v103
    v_and_b32 v2, 2, v2
    s_mov_b32 exec_lo, 0x000f000f
    s_mov_b32 exec_hi, 0x000f000f
    v_readfirstlane_b32 s100, v2
    ds_write_b128 v38, v[116:119]
    ds_write_b128 v38, v[120:123] offset:256
    s_mov_b64 exec, -1
    s_waitcnt lgkmcnt(0)
    s_barrier
    ds_read_b128 v[68:71], v39
    ds_read_b128 v[72:75], v39 offset:64
    global_load_dwordx4 v[76:79], v49, s[20:21] offset:-4096 nt
    v_mov_b32 v4, 0x3db504f3
    s_waitcnt lgkmcnt(0)
    v_cvt_pk_bf16_f32 v68, 0, v68
    v_cvt_pk_bf16_f32 v69, 0, v69
    v_cvt_pk_bf16_f32 v70, 0, v70
    v_cvt_pk_bf16_f32 v71, 0, v71
    v_cvt_pk_bf16_f32 v72, 0, v72
    v_cvt_pk_bf16_f32 v73, 0, v73
    v_cvt_pk_bf16_f32 v74, 0, v74
    v_cvt_pk_bf16_f32 v75, 0, v75
    v_pk_mul_f32 v[68:69], v[68:69], v[4:5] op_sel_hi:[1,0]
    v_pk_mul_f32 v[70:71], v[70:71], v[4:5] op_sel_hi:[1,0]
    v_pk_mul_f32 v[72:73], v[72:73], v[4:5] op_sel_hi:[1,0]
    v_pk_mul_f32 v[74:75], v[74:75], v[4:5] op_sel_hi:[1,0]
    v_cvt_pk_bf16_f32 v68, 0, v68
    v_cvt_pk_bf16_f32 v69, 0, v69
    v_cvt_pk_bf16_f32 v70, 0, v70
    v_cvt_pk_bf16_f32 v71, 0, v71
    v_cvt_pk_bf16_f32 v72, 0, v72
    v_cvt_pk_bf16_f32 v73, 0, v73
    v_cvt_pk_bf16_f32 v74, 0, v74
    v_cvt_pk_bf16_f32 v75, 0, v75
    s_waitcnt lgkmcnt(0)
    v_max3_f32 v26, v68, v69, v70
    v_max3_f32 v26, v26, v71, v72
    v_max3_f32 v26, v26, v73, v74
    v_max_f32 v26, v26, v75
    s_nop 1
    v_max_f32_dpp v26, v26, v26 row_ror:4 row_mask:0xf bank_mask:0xf
    s_nop 1
    v_max_f32_dpp v26, v26, v26 row_ror:8 row_mask:0xf bank_mask:0xf
    v_mov_b32 v2, v26
    s_nop 1
    v_permlane16_swap_b32 v26, v2
    v_max_f32 v26, v26, v2
    v_mov_b32 v2, v26
    s_nop 1
    v_permlane32_swap_b32 v26, v2
    v_max_f32 v26, v26, v2
    v_mul_f32 v26, s46, v26
    v_fma_f32 v68, v68, s46, -v26
    v_fma_f32 v69, v69, s46, -v26
    v_fma_f32 v70, v70, s46, -v26
    v_fma_f32 v71, v71, s46, -v26
    v_fma_f32 v72, v72, s46, -v26
    v_fma_f32 v73, v73, s46, -v26
    v_fma_f32 v74, v74, s46, -v26
    v_fma_f32 v75, v75, s46, -v26
    v_exp_f32 v68, v68
    v_exp_f32 v69, v69
    v_exp_f32 v70, v70
    v_exp_f32 v71, v71
    v_exp_f32 v72, v72
    v_exp_f32 v73, v73
    v_exp_f32 v74, v74
    v_exp_f32 v75, v75
    v_cvt_pk_bf16_f32 v52, v68, v69
    v_cvt_pk_bf16_f32 v53, v70, v71
    v_cvt_pk_bf16_f32 v54, v72, v73
    v_cvt_pk_bf16_f32 v55, v74, v75
    v_pk_add_f32 v[68:69], v[68:69], v[70:71]
    v_pk_add_f32 v[72:73], v[72:73], v[74:75]
    v_mov_b32_dpp v56, v52 row_ror:12 row_mask:0xf bank_mask:0xf
    v_mov_b32_dpp v57, v53 row_ror:12 row_mask:0xf bank_mask:0xf
    v_mov_b32_dpp v58, v54 row_ror:12 row_mask:0xf bank_mask:0xf
    v_mov_b32_dpp v59, v55 row_ror:12 row_mask:0xf bank_mask:0xf
    v_mov_b32_dpp v60, v52 row_ror:8 row_mask:0xf bank_mask:0xf
    v_mov_b32_dpp v61, v53 row_ror:8 row_mask:0xf bank_mask:0xf
    v_mov_b32_dpp v62, v54 row_ror:8 row_mask:0xf bank_mask:0xf
    v_mov_b32_dpp v63, v55 row_ror:8 row_mask:0xf bank_mask:0xf
    v_mov_b32_dpp v64, v52 row_ror:4 row_mask:0xf bank_mask:0xf
    v_mov_b32_dpp v65, v53 row_ror:4 row_mask:0xf bank_mask:0xf
    v_mov_b32_dpp v66, v54 row_ror:4 row_mask:0xf bank_mask:0xf
    v_mov_b32_dpp v67, v55 row_ror:4 row_mask:0xf bank_mask:0xf
    v_pk_add_f32 v[68:69], v[68:69], v[72:73]
    v_add_f32 v27, v68, v69
    s_nop 1
    v_add_f32_dpp v27, v27, v27 row_ror:4 row_mask:0xf bank_mask:0xf
    s_nop 1
    v_add_f32_dpp v27, v27, v27 row_ror:8 row_mask:0xf bank_mask:0xf
    v_mov_b32 v2, v27
    s_nop 1
    v_permlane16_swap_b32 v27, v2
    v_add_f32 v27, v27, v2
    v_mov_b32 v2, v27
    s_nop 1
    v_permlane32_swap_b32 v27, v2
    v_add_f32 v27, v27, v2
    s_cmp_lg_u32 s32, 3
    s_cbranch_scc1 L_ml_skip
    v_mov_b32 v72, v26
    v_mov_b32 v73, v27
    v_mov_b32 v74, s40
    v_mov_b32 v75, s40
    s_mov_b64 exec, 15
    s_cmp_lg_u32 s100, 0
    s_cbranch_scc1 L_ml_far
    global_store_dwordx4 v43, v[72:75], s[28:29]
L_ml_done:
    s_mov_b64 exec, -1
L_ml_skip:
    global_load_dwordx4 v[80:83], v49, s[20:21] offset:0 nt
    global_load_dwordx4 v[84:87], v47, s[12:13] nt
L_tailcode:
    global_load_dwordx4 v[68:71], v34, s[28:29] sc1
    s_waitcnt vmcnt(8)
    v_add_u32 v9, 0x20000, v47
    global_load_dwordx4 v[88:91], v9, s[12:13] nt
    s_waitcnt vmcnt(8)
    v_add_u32 v9, 0x40000, v47
    global_load_dwordx4 v[92:95], v9, s[12:13] nt
    s_waitcnt vmcnt(8)
    v_add_u32 v9, 0x60000, v47
    global_load_dwordx4 v[96:99], v9, s[12:13] nt
    s_waitcnt vmcnt(9)
    s_barrier
    ds_read_b64_tr_b16 v[124:125], v40 offset:0
    ds_read_b64_tr_b16 v[126:127], v40 offset:4096
    ds_read_b64_tr_b16 v[128:129], v41 offset:0
    ds_read_b64_tr_b16 v[130:131], v41 offset:4096
    ds_read_b64_tr_b16 v[132:133], v40 offset:8192
    ds_read_b64_tr_b16 v[134:135], v40 offset:12288
    ds_read_b64_tr_b16 v[136:137], v41 offset:8192
    ds_read_b64_tr_b16 v[138:139], v41 offset:12288
    ds_read_b64_tr_b16 v[140:141], v40 offset:16384
    ds_read_b64_tr_b16 v[142:143], v40 offset:20480
    ds_read_b64_tr_b16 v[144:145], v41 offset:16384
    ds_read_b64_tr_b16 v[146:147], v41 offset:20480
    s_waitcnt lgkmcnt(10)
    v_mfma_f32_16x16x32_bf16 v[116:119], v[124:127], v[52:55], 0
    s_waitcnt lgkmcnt(8)
    v_mfma_f32_16x16x32_bf16 v[120:123], v[128:131], v[52:55], 0
    s_waitcnt lgkmcnt(6)
    v_mfma_f32_16x16x32_bf16 v[116:119], v[132:135], v[56:59], v[116:119]
    s_waitcnt lgkmcnt(4)
    v_mfma_f32_16x16x32_bf16 v[120:123], v[136:139], v[56:59], v[120:123]
    s_waitcnt lgkmcnt(2)
    v_mfma_f32_16x16x32_bf16 v[116:119], v[140:143], v[60:63], v[116:119]
    s_waitcnt lgkmcnt(0)
    v_mfma_f32_16x16x32_bf16 v[120:123], v[144:147], v[60:63], v[120:123]
    s_waitcnt vmcnt(7)
    s_barrier
    ds_read_b64_tr_b16 v[148:149], v40 offset:24576
    ds_read_b64_tr_b16 v[150:151], v40 offset:28672
    ds_read_b64_tr_b16 v[152:153], v41 offset:24576
    ds_read_b64_tr_b16 v[154:155], v41 offset:28672
    s_waitcnt lgkmcnt(2)
    v_mfma_f32_16x16x32_bf16 v[116:119], v[148:151], v[64:67], v[116:119]
    s_waitcnt lgkmcnt(0)
    v_mfma_f32_16x16x32_bf16 v[120:123], v[152:155], v[64:67], v[120:123]
    s_mov_b32 exec_lo, 0x000f000f
    s_mov_b32 exec_hi, 0x000f000f
    s_nop 3
    v_and_or_b32 v116, v116, s42, v14
    v_and_or_b32 v117, v117, s42, v14
    v_and_or_b32 v118, v118, s42, v14
    v_and_or_b32 v119, v119, s42, v14
    v_and_or_b32 v120, v120, s42, v14
    v_and_or_b32 v121, v121, s42, v14
    v_and_or_b32 v122, v122, s42, v14
    v_and_or_b32 v123, v123, s42, v14
    s_cmp_lg_u32 s100, 0
    s_cbranch_scc1 L_o_far
    global_store_dwordx4 v42, v[116:119], s[28:29] offset:0
    global_store_dwordx4 v42, v[120:123], s[28:29] offset:256
L_o_done:
    s_mov_b64 exec, -1
    v_mov_b32 v72, 0
    v_mov_b32 v73, 0
    v_mov_b32 v74, 0
    v_mov_b32 v75, 0
    s_cmp_eq_u32 s48, 0
    s_cbranch_scc1 L_mlp_done
    s_waitcnt vmcnt(5)
L_h_chk:
    v_xor_b32 v68, s3, v68
    v_xor_b32 v69, s41, v69
    v_xor_b32 v70, s41, v70
    v_xor_b32 v71, s41, v71
    v_or3_b32 v2, v69, v70, v71
    v_and_b32 v4, 0xff0, v68
    v_and_b32 v2, 0xfff, v2
    v_or_b32 v2, v2, v4
    v_cmp_ne_u32 vcc, 0, v2
    s_cbranch_vccnz L_h_retry
    v_and_b32 v68, s42, v68
    s_nop 1
    v_permlane32_swap_b32 v68, v70
    v_permlane32_swap_b32 v69, v71
    v_pk_add_f32 v[68:69], v[68:69], v[70:71]
    s_nop 1
    v_permlane16_swap_b32 v68, v69
    v_add_f32 v68, v68, v69
    s_nop 1
    v_add_f32_dpp v68, v68, v68 row_ror:8 row_mask:0xf bank_mask:0xf
    v_cvt_pk_bf16_f32 v68, 0, v68
    v_add_f32 v68, v68, v25
    v_cvt_pk_bf16_f32 v68, 0, v68
    v_mul_f32 v2, v68, v68
    v_mov_b32 v3, 0xc0135761
    v_fmac_f32 v3, 0xbdd2d3e8, v2
    v_mul_f32 v2, v68, v3
    v_exp_f32 v2, v2
    s_nop 0
    v_add_f32 v2, 1.0, v2
    v_rcp_f32 v2, v2
    s_nop 0
    v_mul_f32 v2, v68, v2
    v_cvt_pk_bf16_f32 v2, v2, v2
    s_nop 1
    v_and_b32_dpp v100, v2, v10 quad_perm:[0,0,0,0] row_mask:0xf bank_mask:0xf
    v_and_b32_dpp v101, v2, v11 quad_perm:[0,0,0,0] row_mask:0xf bank_mask:0xf
    v_and_b32_dpp v102, v2, v12 quad_perm:[0,0,0,0] row_mask:0xf bank_mask:0xf
    v_and_b32_dpp v103, v2, v13 quad_perm:[0,0,0,0] row_mask:0xf bank_mask:0xf
    s_waitcnt vmcnt(7)
    v_and_b32_dpp v104, v2, v10 quad_perm:[1,1,1,1] row_mask:0xf bank_mask:0xf
    v_and_b32_dpp v105, v2, v11 quad_perm:[1,1,1,1] row_mask:0xf bank_mask:0xf
    v_and_b32_dpp v106, v2, v12 quad_perm:[1,1,1,1] row_mask:0xf bank_mask:0xf
    v_and_b32_dpp v107, v2, v13 quad_perm:[1,1,1,1] row_mask:0xf bank_mask:0xf
    v_mfma_f32_16x16x32_bf16 v[72:75], v[100:103], v[76:79], 0
    s_nop 0
    v_mfma_f32_16x16x32_bf16 v[72:75], v[104:107], v[80:83], v[72:75]
    s_nop 7
L_mlp_done:
    s_mov_b32 exec_hi, 0
    ds_write_b128 v50, v[72:75] offset:2048
    s_mov_b64 exec, -1
    global_load_dwordx4 v[132:135], v46, s[28:29] offset:0 sc1
    global_load_dwordx4 v[136:139], v46, s[28:29] offset:2048 sc1
    s_waitcnt lgkmcnt(0)
    s_barrier
    s_waitcnt vmcnt(0)
    global_load_dwordx4 v[124:127], v44, s[28:29] sc1
    global_load_dwordx4 v[128:131], v45, s[28:29] sc1
L_ml_chk:
    v_xor_b32 v134, s40, v134
    v_xor_b32 v135, s40, v135
    v_xor_b32 v138, s40, v138
    v_xor_b32 v139, s40, v139
    v_or3_b32 v3, v134, v135, v138
    v_or_b32 v3, v3, v139
    v_cmp_ne_u32 vcc, 0, v3
    s_nop 0
    s_and_b64 exec, exec, vcc
    s_cbranch_scc1 L_ml_again
    s_mov_b64 exec, -1
    v_max_f32 v3, v132, v136
    s_nop 1
    v_max_f32_dpp v3, v3, v3 row_ror:4 row_mask:0xf bank_mask:0xf
    s_nop 1
    v_max_f32_dpp v3, v3, v3 row_ror:8 row_mask:0xf bank_mask:0xf
    v_mov_b32 v2, v3
    s_nop 1
    v_permlane16_swap_b32 v3, v2
    v_max_f32 v3, v3, v2
    v_mov_b32 v2, v3
    s_nop 1
    v_permlane32_swap_b32 v3, v2
    v_max_f32 v3, v3, v2
    v_sub_f32 v4, v132, v3
    v_sub_f32 v6, v136, v3
    v_exp_f32 v4, v4
    v_exp_f32 v6, v6
    v_mul_f32 v3, v4, v133
    v_fmac_f32 v3, v6, v137
    s_nop 1
    v_add_f32_dpp v3, v3, v3 row_ror:4 row_mask:0xf bank_mask:0xf
    s_nop 1
    v_add_f32_dpp v3, v3, v3 row_ror:8 row_mask:0xf bank_mask:0xf
    v_mov_b32 v2, v3
    s_nop 1
    v_permlane16_swap_b32 v3, v2
    v_add_f32 v3, v3, v2
    v_mov_b32 v2, v3
    s_nop 1
    v_permlane32_swap_b32 v3, v2
    v_add_f32 v3, v3, v2
    v_rcp_f32 v3, v3
    s_nop 0
    v_mul_f32 v4, v4, v3
    v_mul_f32 v6, v6, v3
L_o_wait:
    s_waitcnt vmcnt(0)
    v_xor_b32 v124, s41, v124
    v_xor_b32 v125, s41, v125
    v_xor_b32 v126, s41, v126
    v_xor_b32 v127, s41, v127
    v_xor_b32 v128, s41, v128
    v_xor_b32 v129, s41, v129
    v_xor_b32 v130, s41, v130
    v_xor_b32 v131, s41, v131
    v_or3_b32 v2, v124, v125, v126
    v_or3_b32 v2, v2, v127, v128
    v_or3_b32 v2, v2, v129, v130
    v_or_b32 v2, v2, v131
    v_and_b32 v2, 0xfff, v2
    v_cmp_ne_u32 vcc, 0, v2
    s_nop 0
    s_and_b64 exec, exec, vcc
    s_cbranch_scc1 L_o_again
    s_mov_b64 exec, -1
    v_pk_mul_f32 v[124:125], v[124:125], v[4:5] op_sel_hi:[1,0]
    v_pk_mul_f32 v[126:127], v[126:127], v[4:5] op_sel_hi:[1,0]
    v_pk_fma_f32 v[124:125], v[128:129], v[6:7], v[124:125] op_sel_hi:[1,0,1]
    v_pk_fma_f32 v[126:127], v[130:131], v[6:7], v[126:127] op_sel_hi:[1,0,1]
    s_nop 1
    v_permlane32_swap_b32 v124, v126
    v_permlane32_swap_b32 v125, v127
    v_pk_add_f32 v[124:125], v[124:125], v[126:127]
    s_nop 1
    v_permlane16_swap_b32 v124, v125
    v_add_f32 v124, v124, v125
    s_nop 1
    v_add_f32_dpp v124, v124, v124 row_ror:4 row_mask:0xf bank_mask:0xf
    s_nop 1
    v_add_f32_dpp v124, v124, v124 row_ror:8 row_mask:0xf bank_mask:0xf
    v_cvt_pk_bf16_f32 v2, v124, v124
    s_nop 1
    v_and_b32_dpp v100, v2, v10 quad_perm:[0,0,0,0] row_mask:0xf bank_mask:0xf
    v_and_b32_dpp v101, v2, v11 quad_perm:[0,0,0,0] row_mask:0xf bank_mask:0xf
    v_and_b32_dpp v102, v2, v12 quad_perm:[0,0,0,0] row_mask:0xf bank_mask:0xf
    v_and_b32_dpp v103, v2, v13 quad_perm:[0,0,0,0] row_mask:0xf bank_mask:0xf
    v_and_b32_dpp v104, v2, v10 quad_perm:[1,1,1,1] row_mask:0xf bank_mask:0xf
    v_and_b32_dpp v105, v2, v11 quad_perm:[1,1,1,1] row_mask:0xf bank_mask:0xf
    v_and_b32_dpp v106, v2, v12 quad_perm:[1,1,1,1] row_mask:0xf bank_mask:0xf
    v_and_b32_dpp v107, v2, v13 quad_perm:[1,1,1,1] row_mask:0xf bank_mask:0xf
    v_mfma_f32_16x16x32_bf16 v[116:119], v[100:103], v[84:87], 0
    v_and_b32_dpp v108, v2, v10 quad_perm:[2,2,2,2] row_mask:0xf bank_mask:0xf
    v_and_b32_dpp v109, v2, v11 quad_perm:[2,2,2,2] row_mask:0xf bank_mask:0xf
    v_and_b32_dpp v110, v2, v12 quad_perm:[2,2,2,2] row_mask:0xf bank_mask:0xf
    v_and_b32_dpp v111, v2, v13 quad_perm:[2,2,2,2] row_mask:0xf bank_mask:0xf
    v_mfma_f32_16x16x32_bf16 v[116:119], v[104:107], v[88:91], v[116:119]
    v_and_b32_dpp v112, v2, v10 quad_perm:[3,3,3,3] row_mask:0xf bank_mask:0xf
    v_and_b32_dpp v113, v2, v11 quad_perm:[3,3,3,3] row_mask:0xf bank_mask:0xf
    v_and_b32_dpp v114, v2, v12 quad_perm:[3,3,3,3] row_mask:0xf bank_mask:0xf
    v_and_b32_dpp v115, v2, v13 quad_perm:[3,3,3,3] row_mask:0xf bank_mask:0xf
    v_mfma_f32_16x16x32_bf16 v[116:119], v[108:111], v[92:95], v[116:119]
    s_nop 0
    v_mfma_f32_16x16x32_bf16 v[116:119], v[112:115], v[96:99], v[116:119]
    s_mov_b32 exec_hi, 0
    s_nop 6
    ds_write_b128 v50, v[116:119]
    s_waitcnt lgkmcnt(0)
    s_barrier
    s_endpgm
L_comm:
    s_lshl_b32 s33, s30, 5
    s_add_u32 s33, s33, s31
    s_mov_b32 s42, 0xfffff000
    s_mov_b32 s43, 0xffff0000
    s_mov_b32 s47, 0
    s_getreg_b32 s3, hwreg(HW_REG_XCC_ID, 0, 4)
    v_lshlrev_b32 v3, 2, v1
    v_add_u32 v30, 2048, v3
    s_lshl_b32 s36, s33, 8
    s_add_u32 s36, s36, 65536
    v_add_u32 v31, s36, v3
    v_lshlrev_b32 v3, 3, v1
    v_add_u32 v34, 2048, v3
    s_lshl_b32 s36, s33, 10
    s_add_u32 s36, s36, 262144
    v_lshl_add_u32 v35, v1, 4, s36
    s_lshl_b32 s36, s33, 1
    v_and_b32 v3, 1, v16
    v_add_lshl_u32 v157, v3, s36, 1
    s_and_b32 s37, s33, 63
    s_lshl_b32 s37, s37, 4
    s_lshr_b32 s36, s30, 1
    s_lshl_b32 s36, s36, 10
    s_add_u32 s36, s36, s37
    s_add_u32 s36, s36, 262144
    v_lshlrev_b32 v3, 15, v18
    v_lshl_add_u32 v3, v19, 12, v3
    v_add_u32 v156, s36, v3
    v_mov_b32 v158, 0
    v_mov_b32 v159, 0
    s_lshl_b32 s36, s30, 23
    s_add_u32 s36, s36, 0x700000
    s_lshl_b32 s37, s31, 12
    s_add_u32 s36, s36, s37
    v_mov_b32 v3, s36
    s_lshl_b32 s36, s33, 14
    v_mov_b32 v4, s36
    s_lshl_b32 s36, s59, 13
    s_min_u32 s36, s36, 1834944
    v_mov_b32 v5, s36
    s_mov_b64 exec, 1
    global_load_dword v9, v3, s[8:9] nt
    global_load_dword v9, v4, s[12:13] nt
    global_load_dword v9, v5, s[20:21] nt
    s_lshl_b32 s36, s59, 4
    s_min_u32 s36, s36, 3580
    v_mov_b32 v6, s36
    global_load_ushort v9, v6, s[18:19]
    s_mov_b64 exec, -1
    s_lshl_b32 s36, s59, 8
    s_add_u32 s36, s36, 131072
    v_lshl_add_u32 v42, v1, 2, s36
    v_mov_b32 v41, 0
    v_mov_b32 v52, 0
    v_mov_b32 v53, 0
    v_mov_b32 v54, 0
    v_mov_b32 v55, 0
    ds_write_b128 v28, v[52:55] offset:0
    s_waitcnt vmcnt(4) lgkmcnt(0)
    v_readfirstlane_b32 s36, v15
    s_nop 0
    s_mul_i32 s36, s36, 1664525
    s_add_u32 s40, s36, 1013904223
    s_and_b32 s41, s40, 0xfff
    s_xor_b32 s3, s3, s41
    v_mov_b32 v14, s41
    v_and_b32 v2, 3, v1
    v_mov_b32 v3, s3
    v_cmp_eq_u32 vcc, 0, v2
    s_nop 1
    v_cndmask_b32 v33, v14, v3, vcc
    s_barrier
    ds_read2st64_b32 v[52:53], v30 offset0:0 offset1:1
    ds_read2st64_b32 v[54:55], v30 offset0:2 offset1:3
    ds_read2st64_b32 v[56:57], v30 offset0:4 offset1:5
    ds_read2st64_b32 v[58:59], v30 offset0:6 offset1:7
    s_waitcnt lgkmcnt(2)
    v_pk_add_f32 v[52:53], v[52:53], v[54:55]
    s_waitcnt lgkmcnt(0)
    v_pk_add_f32 v[56:57], v[56:57], v[58:59]
    v_pk_add_f32 v[52:53], v[52:53], v[56:57]
    v_add_f32 v40, v52, v53
    v_and_or_b32 v40, v40, s42, v33
    global_store_dword v31, v40, s[28:29]
    s_mov_b64 exec, 1
    s_xor_b32 s36, s30, 4
    s_lshl_b32 s36, s36, 7
    v_mov_b32 v6, s36
    global_load_ushort v9, v6, s[22:23] nt
    s_mov_b64 exec, -1
    s_barrier
    s_cmp_eq_u32 s48, 0
    s_cbranch_scc1 L_hpub_skip
    ds_read2st64_b32 v[52:53], v30 offset0:8 offset1:9
    ds_read2st64_b32 v[54:55], v30 offset0:10 offset1:11
    ds_read2st64_b32 v[56:57], v30 offset0:12 offset1:13
    ds_read2st64_b32 v[58:59], v30 offset0:14 offset1:15
    s_waitcnt lgkmcnt(2)
    v_pk_add_f32 v[52:53], v[52:53], v[54:55]
    s_waitcnt lgkmcnt(0)
    v_pk_add_f32 v[56:57], v[56:57], v[58:59]
    v_pk_add_f32 v[52:53], v[52:53], v[56:57]
    v_add_f32 v41, v52, v53
    v_and_or_b32 v41, v41, s42, v33
    global_store_dword v42, v41, s[28:29]
L_hpub_skip:
    s_mov_b32 s39, 0
L_lazy:
    ds_read_b128 v[52:55], v28 offset:0
    s_add_u32 s39, s39, 1
    s_cmp_gt_u32 s39, 48
    s_cbranch_scc1 L_lazy_late
    s_waitcnt lgkmcnt(0)
    v_min3_u32 v2, v52, v53, v54
    v_min_u32 v2, v2, v55
    v_cmp_eq_u32 vcc, 0, v2
    s_cbranch_vccnz L_lazy
    v_max3_u32 v2, v52, v53, v54
    v_max_u32 v2, v2, v55
    v_cmp_eq_u32 vcc, 1, v2
    s_cbranch_vccz L_lazy_late
L_lazy_done:
    s_barrier
    s_barrier
    s_lshl_b32 s36, s33, 11
    s_add_u32 s36, s36, 524288
    v_lshl_add_u32 v2, v1, 6, s36
    s_lshl_b32 s36, s33, 7
    s_add_u32 s36, s36, 196608
    v_writelane_b32 v2, s36, 32
    s_mov_b32 exec_hi, 1
    global_load_dword v9, v2, s[28:29]
    s_mov_b32 exec_hi, -1
    s_barrier
    s_barrier
    s_barrier
    ds_read_b64 v[56:57], v34 offset:2048
    ds_read_b64 v[58:59], v34 offset:2560
    ds_read_b64 v[60:61], v34 offset:3072
    ds_read_b64 v[62:63], v34 offset:3584
    s_waitcnt lgkmcnt(2)
    v_pk_add_f32 v[54:55], v[56:57], v[58:59]
    s_waitcnt lgkmcnt(0)
    v_pk_add_f32 v[60:61], v[60:61], v[62:63]
    v_pk_add_f32 v[54:55], v[54:55], v[60:61]
    v_and_or_b32 v54, v54, s42, v14
    v_and_or_b32 v55, v55, s42, v14
    s_barrier
    ds_read_b64 v[56:57], v34 offset:0
    ds_read_b64 v[58:59], v34 offset:512
    ds_read_b64 v[60:61], v34 offset:1024
    ds_read_b64 v[62:63], v34 offset:1536
    s_waitcnt lgkmcnt(2)
    v_pk_add_f32 v[52:53], v[56:57], v[58:59]
    s_waitcnt lgkmcnt(1)
    v_pk_add_f32 v[52:53], v[52:53], v[60:61]
    s_waitcnt lgkmcnt(0)
    v_pk_add_f32 v[52:53], v[52:53], v[62:63]
    v_and_or_b32 v52, v52, s42, v14
    v_and_or_b32 v53, v53, s42, v14
    global_store_dwordx4 v35, v[52:55], s[28:29] sc1
    global_load_short_d16_hi v158, v157, s[22:23]
    global_load_short_d16_hi v159, v157, s[4:5]
    s_waitcnt vmcnt(0)
L_fs_loop:
    global_load_dwordx4 v[68:71], v156, s[28:29] offset:0 sc1
    s_add_u32 s47, s47, 1
    s_cmp_gt_u32 s47, 2097152
    s_cbranch_scc1 L_end
    s_waitcnt vmcnt(0)
    v_xor_b32 v68, s41, v68
    v_xor_b32 v69, s41, v69
    v_xor_b32 v70, s41, v70
    v_xor_b32 v71, s41, v71
    v_or3_b32 v2, v68, v69, v70
    v_or_b32 v2, v2, v71
    v_and_b32 v2, 0xfff, v2
    v_cmp_ne_u32 vcc, 0, v2
    s_nop 0
    s_and_b64 exec, exec, vcc
    s_cbranch_scc1 L_fs_loop
    s_mov_b64 exec, -1
    v_permlane32_swap_b32 v68, v70
    v_permlane32_swap_b32 v69, v71
    v_pk_add_f32 v[68:69], v[68:69], v[70:71]
    s_nop 1
    v_permlane16_swap_b32 v68, v69
    v_add_f32 v68, v68, v69
    s_nop 1
    v_add_f32_dpp v68, v68, v68 row_ror:8 row_mask:0xf bank_mask:0xf
    s_nop 1
    v_add_f32_dpp v68, v68, v68 row_ror:4 row_mask:0xf bank_mask:0xf
    s_nop 1
    v_add_f32_dpp v68, v68, v68 row_ror:2 row_mask:0xf bank_mask:0xf
    s_nop 1
    v_add_f32_dpp v68, v68, v68 row_ror:1 row_mask:0xf bank_mask:0xf
    v_mov_b32 v69, v68
    s_nop 1
    v_permlane32_swap_b32 v68, v69
    v_cvt_pk_bf16_f32 v69, 0, v69
    v_add_f32 v69, v69, v158
    v_cvt_pk_bf16_f32 v69, 0, v69
    v_mul_f32 v2, 0xbfb8aa3b, v69
    v_exp_f32 v2, v2
    v_cvt_pk_bf16_f32 v68, 0, v68
    v_add_f32 v2, 1.0, v2
    v_rcp_f32 v2, v2
    s_nop 0
    v_mul_f32 v69, v69, v2
    v_cvt_pk_bf16_f32 v69, 0, v69
    v_mul_f32 v69, v69, v68
    v_cvt_pk_bf16_f32 v69, 0, v69
    v_add_f32 v69, v69, v159
    s_mov_b32 exec_lo, 0x00010001
    s_mov_b32 exec_hi, 0
    v_cvt_pk_bf16_f32 v69, v69, v69
    global_store_short v157, v69, s[24:25]
    s_sub_u32 s36, s32, 4
    s_or_b32 s36, s36, s2
    s_cbranch_scc1 L_fin
    s_mov_b64 exec, 1
    v_mov_b32 v3, s40
    global_store_dword v28, v3, s[28:29]
L_fin:
    s_endpgm
L_q_retry:
    s_and_b32 s36, s47, 3
    s_cmp_eq_u32 s36, 3
    s_cselect_b32 s36, 1310720, 0
    v_xor_b32 v33, s36, v33
    global_load_dwordx4 v[100:103], v33, s[28:29] offset:0 sc1
    global_load_dwordx4 v[104:107], v33, s[28:29] offset:256 sc1
    v_xor_b32 v33, s36, v33
    s_add_u32 s47, s47, 1
    s_cmp_gt_u32 s47, 2097152
    s_cbranch_scc1 L_end
    s_waitcnt vmcnt(0)
    s_branch L_q_chk
L_q_far:
    v_and_b32 v100, s42, v100
    v_and_b32 v104, s42, v104
    s_mov_b32 s36, 3
    s_branch L_q_sum
L_ml_far:
    global_store_dwordx4 v43, v[72:75], s[28:29] sc1
    s_branch L_ml_done
L_o_far:
    global_store_dwordx4 v42, v[116:119], s[28:29] offset:0 sc1
    global_store_dwordx4 v42, v[120:123], s[28:29] offset:256 sc1
    s_branch L_o_done
L_h_retry:
    s_and_b32 s36, s47, 3
    s_cmp_eq_u32 s36, 3
    s_cselect_b32 s36, 1310720, 0
    v_xor_b32 v34, s36, v34
    global_load_dwordx4 v[68:71], v34, s[28:29] sc1
    v_xor_b32 v34, s36, v34
    s_add_u32 s47, s47, 1
    s_cmp_gt_u32 s47, 2097152
    s_cbranch_scc1 L_end
    s_waitcnt vmcnt(0)
    s_branch L_h_chk
L_ml_again:
    global_load_dwordx4 v[132:135], v46, s[28:29] offset:0 sc1
    global_load_dwordx4 v[136:139], v46, s[28:29] offset:2048 sc1
    s_add_u32 s47, s47, 1
    s_cmp_gt_u32 s47, 2097152
    s_cbranch_scc1 L_end
    s_waitcnt vmcnt(0)
    s_branch L_ml_chk
L_o_again:
    global_load_dwordx4 v[124:127], v44, s[28:29] sc1
    global_load_dwordx4 v[128:131], v45, s[28:29] sc1
    s_add_u32 s47, s47, 1
    s_cmp_gt_u32 s47, 2097152
    s_cbranch_scc1 L_end
    s_branch L_o_wait
L_lazy_late:
    v_xor_b32 v32, 1310720, v31
    global_store_dword v32, v40, s[28:29] sc1
    s_cmp_eq_u32 s48, 0
    s_cbranch_scc1 L_thr_a
    v_xor_b32 v32, 1310720, v42
    global_store_dword v32, v41, s[28:29] sc1
L_thr_a:
    s_waitcnt lgkmcnt(0)
    s_branch L_lazy_done
L_end:
    s_endpgm
.section .rodata,"a"
.p2align 6
.amdhsa_kernel recurrent_scan__sliding_block_cached__mixer_channel_mlp__decode_kernel
  .amdhsa_next_free_vgpr 160
  .amdhsa_next_free_sgpr 102
  .amdhsa_accum_offset 160
  .amdhsa_group_segment_fixed_size 0
  .amdhsa_kernarg_size 104
  .amdhsa_user_sgpr_count 2
  .amdhsa_user_sgpr_kernarg_segment_ptr 1
  .amdhsa_system_sgpr_workgroup_id_x 1
.end_amdhsa_kernel
```
